```python
import torch

def _softmax(x, axis=-1):
    return torch.softmax(x, dim=axis)
def _gelu(x):
    return torch.nn.functional.gelu(x, approximate="tanh")
def _silu(x):
    return torch.nn.functional.silu(x)
def _sigmoid(x):
    return torch.sigmoid(x)
def _layernorm(x, axis=-1, eps=1e-5):
    m = x.mean(dim=axis, keepdim=True)
    v = x.var(dim=axis, keepdim=True, unbiased=False)
    return (x - m) / torch.sqrt(v + eps)
def _scatter_add(tgt, idx, src, axis=0):
    return tgt.clone().index_add_(axis, idx, src)
def _segment_sum(src, seg, n):
    out = torch.zeros((n,) + src.shape[1:], dtype=src.dtype)
    return out.index_add_(0, seg, src)
def _pad(x, pw):
    flat = tuple(v for pair in reversed(pw) for v in pair)
    return torch.nn.functional.pad(x, flat)

kernel_name = 'standalone__geglu_ffn__sampling'

def setup_inputs():

    _w = (lambda a: (lambda t: t.to(torch.bfloat16) if t.is_floating_point() else t)(torch.as_tensor(a)))
    B, S, D, F = 8, 8, 1024, 3584
    return {
        "x": _w((lambda *s: torch.randn(*s, dtype=torch.bfloat16) * 0.05)(B, S, D)),
        "w_gate": _w((lambda *s: torch.randn(*s, dtype=torch.bfloat16) * 0.05)(D, F)),
        "w_up": _w((lambda *s: torch.randn(*s, dtype=torch.bfloat16) * 0.05)(D, F)),
        "w_down": _w((lambda *s: torch.randn(*s, dtype=torch.bfloat16) * 0.05)(F, D)),
    }

def reference(x, w_gate, w_up, w_down):
    return (_gelu(x @ w_gate) * (x @ w_up)) @ w_down
```

```asm
; @launch grid=(256,1,1) block=(512,1,1) lds=131072
.amdgcn_target "amdgcn-amd-amdhsa--gfx950"
.text
.globl standalone__geglu_ffn__sampling_kernel
.p2align 8
.type standalone__geglu_ffn__sampling_kernel,@function
standalone__geglu_ffn__sampling_kernel:
    s_cmp_ge_u32 s2, 256
    s_cbranch_scc1 L_done
    s_load_dwordx2 s[32:33], s[0:1], 8
    s_load_dwordx2 s[36:37], s[0:1], 16
    s_load_dwordx2 s[28:29], s[0:1], 0
    s_load_dwordx2 s[52:53], s[0:1], 48
    s_load_dwordx2 s[40:41], s[0:1], 24
    s_load_dwordx2 s[44:45], s[0:1], 32
    v_lshrrev_b32 v1, 6, v0
    v_xor_b32 v1, 4, v1
    v_and_b32 v2, 63, v0
    v_readfirstlane_b32 s27, v1
    s_mov_b32 s34, 7340032
    s_mov_b32 s35, 0x00020000
    s_mov_b32 s38, 7340032
    s_mov_b32 s39, 0x00020000
    s_mov_b32 s30, 131072
    s_mov_b32 s31, 0x00020000
    s_mov_b32 s54, 268435456
    s_mov_b32 s55, 0x00020000
    s_mov_b32 s42, 7340032
    s_mov_b32 s43, 0x00020000
    s_mov_b32 s46, 131072
    s_mov_b32 s47, 0x00020000
    s_and_b32 s18, s2, 7
    s_lshr_b32 s19, s2, 3
    s_and_b32 s3, s27, 3
    v_lshrrev_b32 v3, 4, v2
    s_cmp_lt_u32 s27, 4
    s_cbranch_scc1 L_math
    v_lshrrev_b32 v5, 3, v2
    v_and_b32 v4, 6, v5
    v_and_b32 v6, 7, v2
    v_xor_b32 v4, v4, v6
    v_lshlrev_b32 v4, 4, v4
    v_lshl_add_u32 v6, v5, 11, v4
    s_lshl_b32 s58, s3, 10
    s_mov_b32 s62, s58
    s_and_b32 s63, s19, 1
    s_lshl_b32 s63, s63, 1
    s_and_b32 s57, s3, 2
    s_lshl_b32 s57, s57, 1
    s_add_u32 s63, s63, s57
    s_and_b32 s57, s3, 1
    s_add_u32 s63, s63, s57
    s_lshl_b32 s63, s63, 14
    s_cmp_lg_u32 s3, 0
    s_cbranch_scc1 L_load
    v_mul_u32_u24 v9, 9363, v2
    v_lshrrev_b32 v9, 16, v9
    v_mul_u32_u24 v5, 7, v9
    v_sub_u32 v5, v2, v5
    v_min_u32 v9, 8, v9
    v_mul_u32_u24 v9, 7168, v9
    v_lshl_add_u32 v9, v5, 7, v9
    s_mul_i32 s59, s18, 896
    s_sub_u32 s23, s19, 14
    s_lshr_b32 s60, s23, 1
    s_and_b32 s8, s23, 1
    s_mul_i32 s61, s60, 64512
    s_add_u32 s59, s59, s61
    v_lshlrev_b32 v7, 7, v2
    s_and_b32 s57, s19, 15
    s_lshl_b32 s57, s57, 13
    s_mov_b32 s6, 7340032
    s_mov_b32 s7, 0x00020000
    s_cmp_lt_u32 s19, 14
    s_waitcnt lgkmcnt(0)
    s_cbranch_scc1 L_ct
    buffer_load_dword v16, v7, s[28:31], s57 offen
    s_cmp_lg_u32 s8, 0
    s_cselect_b64 s[4:5], s[36:37], s[32:33]
L_pf:
    buffer_load_dword v16, v9, s[4:7], s59 offen
    s_add_u32 s59, s59, 580608
    s_cmp_lt_u32 s59, 6967296
    s_cbranch_scc1 L_pf
    s_mul_i32 s60, s60, 21504
    s_sub_u32 s59, s59, s60
    s_mov_b32 exec_hi, 0x3ff
    buffer_load_dword v16, v9, s[4:7], s59 offen
    s_mul_i32 s60, s18, 64512
    s_mul_i32 s61, s23, 3584
    s_add_u32 s60, s60, s61
    s_add_u32 s60, s60, 65536
    s_mov_b64 exec, 0xfffffff
    buffer_load_dword v16, v7, s[52:55], s60 offen sc1
    s_mov_b64 exec, -1
    s_branch L_stream
L_load:
    s_cmp_ge_u32 s19, 14
    s_waitcnt lgkmcnt(0)
    s_cbranch_scc1 L_stream
    s_branch L_cl
L_ct:
L_cl:
    s_mov_b32 s60, s63
L_x0:
    s_mov_b32 m0, s62
    s_add_u32 s62, s62, 4096
    buffer_load_dwordx4 v6, s[28:31], s60 offen lds
    s_add_u32 s60, s60, 128
    s_cmp_lt_u32 s62, 65536
    s_cbranch_scc1 L_x0
    s_load_dword s25, s[52:53], 0
    v_lshrrev_b32 v5, 5, v2
    v_bfe_u32 v7, v2, 3, 2
    v_lshl_add_u32 v5, v5, 3, v7
    v_mul_u32_u24 v5, 7168, v5
    v_add_u32 v7, v5, v4
    s_and_b32 s57, s3, 1
    s_lshl_b32 s57, s57, 4
    s_lshr_b32 s59, s3, 1
    s_lshl_b32 s59, s59, 2
    s_add_u32 s57, s57, s59
    s_mul_i32 s57, s57, 7168
    s_mul_i32 s59, s18, 896
    s_add_u32 s57, s57, s59
    s_lshr_b32 s59, s19, 1
    s_lshl_b32 s59, s59, 7
    s_add_u32 s59, s57, s59
    s_mov_b32 s63, s58
    s_mov_b32 s90, 0
    s_add_u32 m0, s63, 65536
    s_add_u32 s90, s90, 1
    buffer_load_dwordx4 v7, s[32:35], s59 offen lds
    s_add_u32 m0, s63, 69632
    s_add_u32 s61, s59, 229376
    buffer_load_dwordx4 v7, s[36:39], s59 offen lds
    s_add_u32 m0, s63, 73728
    s_add_u32 s59, s59, 458752
    buffer_load_dwordx4 v7, s[32:35], s61 offen lds
    s_add_u32 m0, s63, 77824
    s_add_u32 s63, s63, 16384
    buffer_load_dwordx4 v7, s[36:39], s61 offen lds
    s_and_b32 s63, s63, 0xffff
    s_add_u32 m0, s63, 65536
    s_add_u32 s90, s90, 1
    buffer_load_dwordx4 v7, s[32:35], s59 offen lds
    s_add_u32 m0, s63, 69632
    s_add_u32 s61, s59, 229376
    buffer_load_dwordx4 v7, s[36:39], s59 offen lds
    s_add_u32 m0, s63, 73728
    s_add_u32 s59, s59, 458752
    buffer_load_dwordx4 v7, s[32:35], s61 offen lds
    s_add_u32 m0, s63, 77824
    s_add_u32 s63, s63, 16384
    buffer_load_dwordx4 v7, s[36:39], s61 offen lds
    s_and_b32 s63, s63, 0xffff
L_ldw:
    s_add_u32 m0, s63, 65536
    s_add_u32 s90, s90, 1
    buffer_load_dwordx4 v7, s[32:35], s59 offen lds
    s_add_u32 m0, s63, 69632
    s_add_u32 s61, s59, 229376
    buffer_load_dwordx4 v7, s[36:39], s59 offen lds
    s_add_u32 m0, s63, 73728
    s_add_u32 s59, s59, 458752
    buffer_load_dwordx4 v7, s[32:35], s61 offen lds
    s_add_u32 m0, s63, 77824
    s_add_u32 s63, s63, 16384
    buffer_load_dwordx4 v7, s[36:39], s61 offen lds
    s_and_b32 s63, s63, 0xffff
    s_waitcnt vmcnt(8) lgkmcnt(0)
    s_barrier
    s_cmp_lt_u32 s90, 16
    s_cbranch_scc1 L_ldw
    s_cmp_ge_u32 s19, 14
    s_cselect_b32 s20, 1, 0
    s_mul_i32 s21, s20, 14
    s_sub_u32 s23, s19, s21
    s_cmp_ge_u32 s23, 3
    s_addc_u32 s22, s23, 0
    s_cmp_ge_u32 s23, 10
    s_addc_u32 s21, s22, 0
    s_mov_b32 s24, 0
    s_cmp_lt_u32 s19, 28
    s_cbranch_scc1 L_ids0
    s_and_b32 s20, s19, 1
    s_and_b32 s21, s19, 2
    s_lshl_b32 s21, s21, 2
    s_add_u32 s21, s21, 3
    s_mov_b32 s24, s20
L_ids0:
    s_mul_i32 s56, s18, 917504
    s_lshl_b32 s57, s3, 14
    s_add_u32 s56, s56, s57
    s_lshl_b32 s57, s21, 7
    s_add_u32 s56, s56, s57
    s_lshl_b32 s57, s24, 18
    s_add_u32 s56, s56, s57
    s_add_u32 s94, s58, 0
    s_lshl_b32 s96, s21, 1
    s_add_u32 s96, s96, s20
    s_lshl_b32 s96, s96, 16
    s_add_u32 s96, s96, 2097152
    s_lshl_b32 s91, s18, 13
    s_add_u32 s96, s96, s91
    s_lshl_b32 s91, s3, 8
    s_add_u32 s96, s96, s91
    s_lshl_b32 s91, s20, 3
    s_add_u32 s91, s91, s18
    s_lshl_b32 s91, s91, 13
    s_lshl_b32 s92, s21, 7
    s_add_u32 s91, s91, s92
    s_lshl_b32 s92, s3, 5
    s_add_u32 s91, s91, s92
    s_waitcnt vmcnt(4)
    s_barrier
    s_waitcnt vmcnt(0)
    s_barrier
    s_mov_b32 m0, s94
    s_add_u32 s95, s56, 458752
    buffer_load_dwordx4 v6, s[40:43], s56 offen lds
    s_add_u32 m0, s94, 28672
    s_add_u32 s56, s56, 65536
    buffer_load_dwordx4 v6, s[40:43], s95 offen lds
    s_add_u32 s94, s94, 4096
    s_mov_b32 m0, s94
    s_add_u32 s95, s56, 458752
    buffer_load_dwordx4 v6, s[40:43], s56 offen lds
    s_add_u32 m0, s94, 28672
    s_add_u32 s56, s56, 65536
    buffer_load_dwordx4 v6, s[40:43], s95 offen lds
    s_add_u32 s94, s94, 4096
    s_mov_b32 m0, s94
    s_add_u32 s95, s56, 458752
    buffer_load_dwordx4 v6, s[40:43], s56 offen lds
    s_add_u32 m0, s94, 28672
    s_add_u32 s56, s56, 65536
    buffer_load_dwordx4 v6, s[40:43], s95 offen lds
    s_add_u32 s94, s94, 4096
    s_barrier
    s_branch L_wd_3
L_stream:
    s_load_dword s25, s[52:53], 0
    s_cmp_ge_u32 s19, 14
    s_cselect_b32 s20, 1, 0
    s_mul_i32 s21, s20, 14
    s_sub_u32 s23, s19, s21
    s_cmp_ge_u32 s23, 3
    s_addc_u32 s22, s23, 0
    s_cmp_ge_u32 s23, 10
    s_addc_u32 s21, s22, 0
    s_mov_b32 s24, 0
    s_cmp_lt_u32 s19, 28
    s_cbranch_scc1 L_ids1
    s_and_b32 s20, s19, 1
    s_and_b32 s21, s19, 2
    s_lshl_b32 s21, s21, 2
    s_add_u32 s21, s21, 3
    s_mov_b32 s24, s20
L_ids1:
    s_mul_i32 s56, s18, 917504
    s_lshl_b32 s57, s3, 14
    s_add_u32 s56, s56, s57
    s_lshl_b32 s57, s21, 7
    s_add_u32 s56, s56, s57
    s_lshl_b32 s57, s24, 18
    s_add_u32 s56, s56, s57
    s_add_u32 s94, s58, 0
    s_lshl_b32 s96, s21, 1
    s_add_u32 s96, s96, s20
    s_lshl_b32 s96, s96, 16
    s_add_u32 s96, s96, 2097152
    s_lshl_b32 s91, s18, 13
    s_add_u32 s96, s96, s91
    s_lshl_b32 s91, s3, 8
    s_add_u32 s96, s96, s91
    s_lshl_b32 s91, s20, 3
    s_add_u32 s91, s91, s18
    s_lshl_b32 s91, s91, 13
    s_lshl_b32 s92, s21, 7
    s_add_u32 s91, s91, s92
    s_lshl_b32 s92, s3, 5
    s_add_u32 s91, s91, s92
    s_waitcnt lgkmcnt(0)
    s_barrier
L_wd:
    s_mov_b32 m0, s94
    s_add_u32 s95, s56, 458752
    buffer_load_dwordx4 v6, s[40:43], s56 offen lds
    s_add_u32 m0, s94, 28672
    s_add_u32 s56, s56, 65536
    buffer_load_dwordx4 v6, s[40:43], s95 offen lds
    s_add_u32 s94, s94, 4096
    s_mov_b32 m0, s94
    s_add_u32 s95, s56, 458752
    buffer_load_dwordx4 v6, s[40:43], s56 offen lds
    s_add_u32 m0, s94, 28672
    s_add_u32 s56, s56, 65536
    buffer_load_dwordx4 v6, s[40:43], s95 offen lds
    s_add_u32 s94, s94, 4096
    s_mov_b32 m0, s94
    s_add_u32 s95, s56, 458752
    buffer_load_dwordx4 v6, s[40:43], s56 offen lds
    s_add_u32 m0, s94, 28672
    s_add_u32 s56, s56, 65536
    buffer_load_dwordx4 v6, s[40:43], s95 offen lds
    s_add_u32 s94, s94, 4096
L_wd_3:
    s_mul_i32 s60, s24, 458752
    s_sub_u32 s56, s56, s60
    s_mov_b32 m0, s94
    s_add_u32 s95, s56, 458752
    buffer_load_dwordx4 v6, s[40:43], s56 offen lds
    s_add_u32 m0, s94, 28672
    s_add_u32 s56, s56, 65536
    buffer_load_dwordx4 v6, s[40:43], s95 offen lds
    s_add_u32 s94, s94, 4096
    s_mov_b32 m0, s94
    s_add_u32 s95, s56, 458752
    buffer_load_dwordx4 v6, s[40:43], s56 offen lds
    s_add_u32 m0, s94, 28672
    s_add_u32 s56, s56, 65536
    buffer_load_dwordx4 v6, s[40:43], s95 offen lds
    s_add_u32 s94, s94, 4096
    s_mov_b32 m0, s94
    s_add_u32 s95, s56, 458752
    buffer_load_dwordx4 v6, s[40:43], s56 offen lds
    s_add_u32 m0, s94, 28672
    s_add_u32 s56, s56, 65536
    buffer_load_dwordx4 v6, s[40:43], s95 offen lds
    s_add_u32 s94, s94, 4096
    s_mov_b32 m0, s94
    s_add_u32 s95, s56, 458752
    buffer_load_dwordx4 v6, s[40:43], s56 offen lds
    s_add_u32 m0, s94, 28672
    s_add_u32 s56, s56, 65536
    buffer_load_dwordx4 v6, s[40:43], s95 offen lds
    s_add_u32 s94, s94, 4096
    s_xor_b32 s26, s25, 1540483477
    s_add_u32 s59, s96, 4096
    s_waitcnt vmcnt(8)
    s_barrier
    v_lshlrev_b32 v5, 2, v2
    v_and_b32 v10, 3, v2
    v_lshlrev_b32 v4, 3, v10
    v_bfe_u32 v4, s26, v4, 8
    v_bfe_u32 v9, v2, 2, 2
    v_lshlrev_b32 v9, 11, v9
    v_lshl_add_u32 v9, v3, 3, v9
    v_lshl_add_u32 v9, v10, 1, v9
    s_mov_b32 s90, 0
    s_waitcnt vmcnt(0)
    s_barrier
    s_barrier
    s_barrier
L_pollC:
    buffer_load_dword v16, v5, s[52:55], s96 offen offset:0 sc1
    buffer_load_dword v17, v5, s[52:55], s96 offen offset:1024 sc1
    buffer_load_dword v18, v5, s[52:55], s96 offen offset:2048 sc1
    buffer_load_dword v19, v5, s[52:55], s96 offen offset:3072 sc1
    buffer_load_dword v20, v5, s[52:55], s59 offen offset:0 sc1
    buffer_load_dword v21, v5, s[52:55], s59 offen offset:1024 sc1
    buffer_load_dword v22, v5, s[52:55], s59 offen offset:2048 sc1
    buffer_load_dword v23, v5, s[52:55], s59 offen offset:3072 sc1
    s_add_u32 s90, s90, 1
    s_cmp_ge_u32 s90, 1048576
    s_cbranch_scc1 L_done
    s_waitcnt vmcnt(0)
    v_xor_b32 v16, v4, v16
    v_xor_b32 v17, v4, v17
    v_xor_b32 v18, v4, v18
    v_xor_b32 v19, v4, v19
    v_xor_b32 v20, v4, v20
    v_xor_b32 v21, v4, v21
    v_xor_b32 v22, v4, v22
    v_xor_b32 v23, v4, v23
    v_or3_b32 v3, v16, v17, v18
    v_or3_b32 v11, v19, v20, v21
    v_or3_b32 v3, v22, v23, v3
    v_or_b32 v3, v3, v11
    v_and_b32 v3, 0xff, v3
    v_cmp_ne_u32 vcc, 0, v3
    v_pk_add_f32 v[24:25], v[16:17], v[18:19]
    v_pk_add_f32 v[26:27], v[20:21], v[22:23]
    s_cbranch_vccnz L_pollC
    v_pk_add_f32 v[16:17], v[24:25], v[26:27]
    v_add_f32 v16, v16, v17
    v_cvt_pk_bf16_f32 v16, v16, v16
    buffer_store_short v16, v9, s[44:47], s91 offen
    s_or_b32 s57, s2, s3
    s_cmp_lg_u32 s57, 0
    s_cbranch_scc1 L_done
    s_barrier
    s_endpgm
L_math:
    s_setprio 1
    s_getreg_b32 s92, hwreg(HW_REG_XCC_ID)
    v_lshlrev_b32 v8, 4, v2
    s_cmp_ge_u32 s19, 14
    s_cselect_b32 s20, 1, 0
    s_mul_i32 s21, s20, 14
    s_sub_u32 s23, s19, s21
    s_cmp_ge_u32 s23, 3
    s_addc_u32 s22, s23, 0
    s_cmp_ge_u32 s23, 10
    s_addc_u32 s21, s22, 0
    s_mov_b32 s24, 0
    s_cmp_lt_u32 s19, 28
    s_cbranch_scc1 L_ids2
    s_and_b32 s20, s19, 1
    s_and_b32 s21, s19, 2
    s_lshl_b32 s21, s21, 2
    s_add_u32 s21, s21, 3
    s_mov_b32 s24, s20
L_ids2:
    s_waitcnt lgkmcnt(0)
    s_load_dword s25, s[52:53], 0
    s_lshl_b32 s57, s18, 1
    s_and_b32 s60, s3, 1
    s_add_u32 s57, s57, s60
    s_mul_i32 s57, s57, 28
    s_lshr_b32 s61, s3, 1
    s_add_u32 s57, s57, s61
    s_and_b32 s91, s19, 1
    s_mul_i32 s91, s91, 13
    s_add_u32 s91, s91, s19
    s_add_u32 s91, s91, s57
    s_mul_i32 s91, s91, 1152
    s_add_u32 s56, s91, 65536
    s_add_u32 s58, s56, 1048576
    s_mul_i32 s57, s57, 1152
    s_add_u32 s57, s57, 66560
    v_and_b32 v216, 1, v2
    v_mul_u32_u24 v216, 13, v216
    v_add_u32 v216, v216, v2
    v_mul_u32_u24 v216, 1152, v216
    v_add_u32 v216, s57, v216
    s_lshl_b32 s57, s18, 7
    s_add_u32 s57, s57, 4100
    v_lshlrev_b32 v217, 10, v2
    v_cmp_gt_u32 vcc, 14, v2
    v_add_u32 v217, s57, v217
    s_nop 0
    v_cndmask_b32 v216, v217, v216, vcc
    s_mov_b32 s94, 0
    s_cmp_ge_u32 s19, 14
    s_cbranch_scc1 L_msetup
    s_mov_b32 s94, 1
    v_and_b32 v9, 15, v2
    v_and_b32 v11, 6, v9
    v_xor_b32 v11, v11, v3
    v_lshlrev_b32 v11, 4, v11
    v_lshl_add_u32 v11, v9, 7, v11
    s_lshl_b32 s62, s60, 11
    v_add_u32 v11, s62, v11
    v_xor_b32 v12, 64, v11
    v_lshrrev_b32 v13, 2, v2
    v_lshlrev_b32 v13, 7, v13
    v_and_b32 v14, 3, v2
    v_lshl_add_u32 v13, v14, 3, v13
    v_bfe_u32 v14, v2, 3, 2
    s_lshl_b32 s62, s61, 1
    v_xor_b32 v14, s62, v14
    v_lshl_add_u32 v13, v14, 5, v13
    v_add_u32 v13, 65536, v13
    v_xor_b32 v14, 32, v13
    v_mov_b32 v16, 0
    v_mov_b32 v17, 0
    v_mov_b32 v18, 0
    v_mov_b32 v19, 0
    v_mov_b32 v20, 0
    v_mov_b32 v21, 0
    v_mov_b32 v22, 0
    v_mov_b32 v23, 0
    v_mov_b32 v24, 0
    v_mov_b32 v25, 0
    v_mov_b32 v26, 0
    v_mov_b32 v27, 0
    v_mov_b32 v28, 0
    v_mov_b32 v29, 0
    v_mov_b32 v30, 0
    v_mov_b32 v31, 0
    v_mov_b32 v72, 0
    v_mov_b32 v73, 0
    v_mov_b32 v74, 0
    v_mov_b32 v75, 0
    v_mov_b32 v76, 0
    v_mov_b32 v77, 0
    v_mov_b32 v78, 0
    v_mov_b32 v79, 0
    v_mov_b32 v80, 0
    v_mov_b32 v81, 0
    v_mov_b32 v82, 0
    v_mov_b32 v83, 0
    v_mov_b32 v84, 0
    v_mov_b32 v85, 0
    v_mov_b32 v86, 0
    v_mov_b32 v87, 0
    v_mov_b32 v88, 0
    v_mov_b32 v89, 0
    v_mov_b32 v90, 0
    v_mov_b32 v91, 0
    v_mov_b32 v92, 0
    v_mov_b32 v93, 0
    v_mov_b32 v94, 0
    v_mov_b32 v95, 0
    v_mov_b32 v96, 0
    v_mov_b32 v97, 0
    v_mov_b32 v98, 0
    v_mov_b32 v99, 0
    v_mov_b32 v100, 0
    v_mov_b32 v101, 0
    v_mov_b32 v102, 0
    v_mov_b32 v103, 0
    v_mov_b32 v104, 0
    v_mov_b32 v105, 0
    v_mov_b32 v106, 0
    v_mov_b32 v107, 0
    v_mov_b32 v108, 0
    v_mov_b32 v109, 0
    v_mov_b32 v110, 0
    v_mov_b32 v111, 0
L_msetup:
    s_and_b32 s60, s3, 1
    s_lshr_b32 s61, s3, 1
    s_lshl_b32 s57, s18, 1
    s_add_u32 s57, s57, s20
    s_lshl_b32 s57, s57, 1
    s_add_u32 s57, s57, s60
    s_lshl_b32 s57, s57, 1
    s_add_u32 s57, s57, s61
    s_mul_i32 s57, s57, 8064
    s_add_u32 s93, s57, 65536
    s_mul_i32 s91, s24, 4608
    s_add_u32 s59, s93, s91
    s_mul_i32 s91, s24, 3456
    s_sub_u32 s57, s93, s91
    s_add_u32 s57, s57, 3456
    v_mul_u32_u24 v208, 1152, v2
    v_bfe_u32 v209, v2, 3, 2
    s_lshl_b32 s62, s61, 1
    v_xor_b32 v209, s62, v209
    v_lshrrev_b32 v10, 2, v2
    v_lshlrev_b32 v10, 7, v10
    v_and_b32 v15, 3, v2
    v_lshl_add_u32 v10, v15, 3, v10
    s_mul_i32 s62, s61, 28672
    s_add_u32 s62, s62, 0
    v_add_u32 v10, s62, v10
    v_xor_b32 v204, 0, v209
    v_lshl_add_u32 v204, v204, 5, v10
    v_xor_b32 v205, 1, v209
    v_lshl_add_u32 v205, v205, 5, v10
    v_xor_b32 v206, 2, v209
    v_lshl_add_u32 v206, v206, 5, v10
    v_xor_b32 v207, 3, v209
    v_lshl_add_u32 v207, v207, 5, v10
    s_lshl_b32 s62, s3, 11
    s_add_u32 s62, s62, 65536
    v_add_u32 v9, s62, v8
    v_xor_b32 v10, 4096, v9
    v_bfe_u32 v209, v2, 2, 2
    v_lshlrev_b32 v209, 13, v209
    v_lshl_add_u32 v209, v3, 6, v209
    v_lshl_add_u32 v15, v15, 4, v209
    s_lshl_b32 s62, s21, 1
    s_add_u32 s62, s62, s20
    s_lshl_b32 s62, s62, 16
    s_add_u32 s62, s62, 2097152
    s_lshl_b32 s91, s60, 15
    s_add_u32 s62, s62, s91
    s_lshl_b32 s91, s18, 10
    s_add_u32 s62, s62, s91
    s_lshl_b32 s91, s61, 9
    s_add_u32 s62, s62, s91
    v_mov_b32 v1, 0xff
    s_mov_b32 s60, 0xbdd2d3e8
    s_mov_b32 s61, 0xbdd2d3e8
    v_mov_b32 v211, 0xc0135761
    s_mov_b32 s90, 0
    s_and_b32 s92, s92, 15
    s_add_u32 s92, s92, 1
    s_mul_i32 s92, s92, 0x9e3779b1
    s_waitcnt lgkmcnt(0)
    s_xor_b32 s26, s25, 1540483477
    s_bfe_u32 s48, s26, 524288
    s_bfe_u32 s49, s26, 524296
    s_bfe_u32 s50, s26, 524304
    s_bfe_u32 s51, s26, 524312
    v_mov_b32 v4, s26
    v_mov_b32 v5, s26
    v_mov_b32 v6, s26
    v_mov_b32 v7, s26
    s_xor_b32 s95, s26, s92
    v_mov_b32 v210, s95
    v_mov_b32 v5, s95
    s_barrier
    s_cmp_lt_u32 s19, 14
    s_cbranch_scc1 L_k0
    s_cmp_lg_u32 s3, 0
    s_cbranch_scc1 L_phase2
    s_lshl_b32 s91, s2, 7
    s_add_u32 s91, s91, 4096
    s_mov_b64 exec, 0xff
    buffer_store_dwordx4 v[4:7], v8, s[52:55], s91 offen sc1
    s_mov_b64 exec, -1
    s_branch L_phase2
L_k:
    s_waitcnt lgkmcnt(0)
    s_barrier
L_k0:
    ds_read_b128 v[32:35], v11 offset:0
    ds_read_b64_tr_b16 v[40:41], v13 offset:0
    ds_read_b64_tr_b16 v[42:43], v13 offset:2048
    v_mfma_f32_16x16x32_bf16 v[16:19], v[80:83], v[72:75], v[16:19]
    ds_read_b64_tr_b16 v[44:45], v14 offset:0
    ds_read_b64_tr_b16 v[46:47], v14 offset:2048
    ds_read_b64_tr_b16 v[48:49], v13 offset:4096
    v_mfma_f32_16x16x32_bf16 v[24:27], v[84:87], v[72:75], v[24:27]
    ds_read_b64_tr_b16 v[50:51], v13 offset:6144
    ds_read_b64_tr_b16 v[52:53], v14 offset:4096
    v_mfma_f32_16x16x32_bf16 v[20:23], v[88:91], v[72:75], v[20:23]
    ds_read_b64_tr_b16 v[54:55], v14 offset:6144
    ds_read_b128 v[36:39], v12 offset:0
    v_mfma_f32_16x16x32_bf16 v[28:31], v[92:95], v[72:75], v[28:31]
    ds_read_b64_tr_b16 v[56:57], v13 offset:8192
    ds_read_b64_tr_b16 v[58:59], v13 offset:10240
    v_mfma_f32_16x16x32_bf16 v[16:19], v[96:99], v[76:79], v[16:19]
    ds_read_b64_tr_b16 v[60:61], v14 offset:8192
    ds_read_b64_tr_b16 v[62:63], v14 offset:10240
    v_mfma_f32_16x16x32_bf16 v[24:27], v[100:103], v[76:79], v[24:27]
    ds_read_b64_tr_b16 v[64:65], v13 offset:12288
    ds_read_b64_tr_b16 v[66:67], v13 offset:14336
    v_mfma_f32_16x16x32_bf16 v[20:23], v[104:107], v[76:79], v[20:23]
    ds_read_b64_tr_b16 v[68:69], v14 offset:12288
    ds_read_b64_tr_b16 v[70:71], v14 offset:14336
    v_mfma_f32_16x16x32_bf16 v[28:31], v[108:111], v[76:79], v[28:31]
    s_waitcnt lgkmcnt(0)
    s_cmp_eq_u32 s90, 7
    s_cbranch_scc1 L_klast
    s_barrier
    ds_read_b128 v[72:75], v11 offset:4096
    ds_read_b64_tr_b16 v[80:81], v13 offset:16384
    ds_read_b64_tr_b16 v[82:83], v13 offset:18432
    v_mfma_f32_16x16x32_bf16 v[16:19], v[40:43], v[32:35], v[16:19]
    ds_read_b64_tr_b16 v[84:85], v14 offset:16384
    ds_read_b64_tr_b16 v[86:87], v14 offset:18432
    ds_read_b64_tr_b16 v[88:89], v13 offset:20480
    v_mfma_f32_16x16x32_bf16 v[24:27], v[44:47], v[32:35], v[24:27]
    ds_read_b64_tr_b16 v[90:91], v13 offset:22528
    ds_read_b64_tr_b16 v[92:93], v14 offset:20480
    v_mfma_f32_16x16x32_bf16 v[20:23], v[48:51], v[32:35], v[20:23]
    ds_read_b64_tr_b16 v[94:95], v14 offset:22528
    ds_read_b128 v[76:79], v12 offset:4096
    v_mfma_f32_16x16x32_bf16 v[28:31], v[52:55], v[32:35], v[28:31]
    ds_read_b64_tr_b16 v[96:97], v13 offset:24576
    ds_read_b64_tr_b16 v[98:99], v13 offset:26624
    v_mfma_f32_16x16x32_bf16 v[16:19], v[56:59], v[36:39], v[16:19]
    ds_read_b64_tr_b16 v[100:101], v14 offset:24576
    ds_read_b64_tr_b16 v[102:103], v14 offset:26624
    v_mfma_f32_16x16x32_bf16 v[24:27], v[60:63], v[36:39], v[24:27]
    ds_read_b64_tr_b16 v[104:105], v13 offset:28672
    ds_read_b64_tr_b16 v[106:107], v13 offset:30720
    v_mfma_f32_16x16x32_bf16 v[20:23], v[64:67], v[36:39], v[20:23]
    ds_read_b64_tr_b16 v[108:109], v14 offset:28672
    ds_read_b64_tr_b16 v[110:111], v14 offset:30720
    v_mfma_f32_16x16x32_bf16 v[28:31], v[68:71], v[36:39], v[28:31]
    v_add_u32 v11, 0x2000, v11
    v_add_u32 v12, 0x2000, v12
    v_xor_b32 v13, 0x8000, v13
    v_xor_b32 v14, 0x8000, v14
    s_add_u32 s90, s90, 1
    s_branch L_k
L_klast:
    v_mfma_f32_16x16x32_bf16 v[16:19], v[40:43], v[32:35], v[16:19]
    v_mfma_f32_16x16x32_bf16 v[24:27], v[44:47], v[32:35], v[24:27]
    v_mfma_f32_16x16x32_bf16 v[20:23], v[48:51], v[32:35], v[20:23]
    v_mfma_f32_16x16x32_bf16 v[28:31], v[52:55], v[32:35], v[28:31]
    v_mfma_f32_16x16x32_bf16 v[16:19], v[56:59], v[36:39], v[16:19]
    v_mfma_f32_16x16x32_bf16 v[24:27], v[60:63], v[36:39], v[24:27]
    v_mfma_f32_16x16x32_bf16 v[20:23], v[64:67], v[36:39], v[20:23]
    v_mfma_f32_16x16x32_bf16 v[28:31], v[68:71], v[36:39], v[28:31]
    s_barrier
    ds_read_b128 v[72:75], v11 offset:4096
    ds_read_b64_tr_b16 v[80:81], v13 offset:16384
    ds_read_b64_tr_b16 v[82:83], v13 offset:18432
    ds_read_b64_tr_b16 v[84:85], v14 offset:16384
    ds_read_b64_tr_b16 v[86:87], v14 offset:18432
    ds_read_b128 v[76:79], v12 offset:4096
    ds_read_b64_tr_b16 v[96:97], v13 offset:24576
    ds_read_b64_tr_b16 v[98:99], v13 offset:26624
    ds_read_b64_tr_b16 v[100:101], v14 offset:24576
    ds_read_b64_tr_b16 v[102:103], v14 offset:26624
    ds_read_b64_tr_b16 v[88:89], v13 offset:20480
    ds_read_b64_tr_b16 v[90:91], v13 offset:22528
    ds_read_b64_tr_b16 v[92:93], v14 offset:20480
    ds_read_b64_tr_b16 v[94:95], v14 offset:22528
    ds_read_b64_tr_b16 v[104:105], v13 offset:28672
    ds_read_b64_tr_b16 v[106:107], v13 offset:30720
    ds_read_b64_tr_b16 v[108:109], v14 offset:28672
    ds_read_b64_tr_b16 v[110:111], v14 offset:30720
    s_waitcnt lgkmcnt(13)
    v_mfma_f32_16x16x32_bf16 v[16:19], v[80:83], v[72:75], v[16:19]
    v_mfma_f32_16x16x32_bf16 v[24:27], v[84:87], v[72:75], v[24:27]
    s_waitcnt lgkmcnt(8)
    v_mfma_f32_16x16x32_bf16 v[16:19], v[96:99], v[76:79], v[16:19]
    v_mfma_f32_16x16x32_bf16 v[24:27], v[100:103], v[76:79], v[24:27]
    s_waitcnt lgkmcnt(4)
    v_mfma_f32_16x16x32_bf16 v[20:23], v[88:91], v[72:75], v[20:23]
    v_mfma_f32_16x16x32_bf16 v[28:31], v[92:95], v[72:75], v[28:31]
    s_waitcnt lgkmcnt(0)
    v_mfma_f32_16x16x32_bf16 v[20:23], v[104:107], v[76:79], v[20:23]
    v_mfma_f32_16x16x32_bf16 v[28:31], v[108:111], v[76:79], v[28:31]
    s_mov_b32 s90, 0
    s_nop 1
    v_cvt_pk_bf16_f32 v16, 0, v16
    v_cvt_pk_bf16_f32 v17, 0, v17
    v_cvt_pk_bf16_f32 v18, 0, v18
    v_cvt_pk_bf16_f32 v19, 0, v19
    v_cvt_pk_bf16_f32 v24, 0, v24
    v_cvt_pk_bf16_f32 v25, 0, v25
    v_cvt_pk_bf16_f32 v26, 0, v26
    v_cvt_pk_bf16_f32 v27, 0, v27
    v_pk_mul_f32 v[32:33], v[16:17], v[16:17]
    v_pk_mul_f32 v[34:35], v[18:19], v[18:19]
    v_pk_mul_f32 v[36:37], v[24:25], v[24:25]
    v_pk_mul_f32 v[38:39], v[26:27], v[26:27]
    v_pk_fma_f32 v[32:33], v[32:33], s[60:61], v[210:211] op_sel:[0,0,1] op_sel_hi:[1,1,1]
    v_pk_fma_f32 v[34:35], v[34:35], s[60:61], v[210:211] op_sel:[0,0,1] op_sel_hi:[1,1,1]
    v_pk_fma_f32 v[36:37], v[36:37], s[60:61], v[210:211] op_sel:[0,0,1] op_sel_hi:[1,1,1]
    v_pk_fma_f32 v[38:39], v[38:39], s[60:61], v[210:211] op_sel:[0,0,1] op_sel_hi:[1,1,1]
    v_pk_mul_f32 v[32:33], v[32:33], v[16:17]
    v_pk_mul_f32 v[34:35], v[34:35], v[18:19]
    v_pk_mul_f32 v[36:37], v[36:37], v[24:25]
    v_pk_mul_f32 v[38:39], v[38:39], v[26:27]
    v_exp_f32 v32, v32
    v_exp_f32 v33, v33
    v_exp_f32 v34, v34
    v_exp_f32 v35, v35
    v_exp_f32 v36, v36
    v_exp_f32 v37, v37
    v_exp_f32 v38, v38
    v_exp_f32 v39, v39
    v_cvt_pk_bf16_f32 v20, 0, v20
    v_cvt_pk_bf16_f32 v21, 0, v21
    v_cvt_pk_bf16_f32 v22, 0, v22
    v_cvt_pk_bf16_f32 v23, 0, v23
    v_cvt_pk_bf16_f32 v28, 0, v28
    v_cvt_pk_bf16_f32 v29, 0, v29
    v_cvt_pk_bf16_f32 v30, 0, v30
    v_cvt_pk_bf16_f32 v31, 0, v31
    v_pk_add_f32 v[32:33], v[32:33], 1.0 op_sel_hi:[1,0]
    v_pk_add_f32 v[34:35], v[34:35], 1.0 op_sel_hi:[1,0]
    v_pk_add_f32 v[36:37], v[36:37], 1.0 op_sel_hi:[1,0]
    v_pk_add_f32 v[38:39], v[38:39], 1.0 op_sel_hi:[1,0]
    v_rcp_f32 v32, v32
    v_rcp_f32 v33, v33
    v_rcp_f32 v34, v34
    v_rcp_f32 v35, v35
    v_rcp_f32 v36, v36
    v_rcp_f32 v37, v37
    v_rcp_f32 v38, v38
    v_rcp_f32 v39, v39
    v_pk_mul_f32 v[32:33], v[32:33], v[16:17]
    v_pk_mul_f32 v[34:35], v[34:35], v[18:19]
    v_pk_mul_f32 v[36:37], v[36:37], v[24:25]
    v_pk_mul_f32 v[38:39], v[38:39], v[26:27]
    v_cvt_pk_bf16_f32 v32, 0, v32
    v_cvt_pk_bf16_f32 v33, 0, v33
    v_cvt_pk_bf16_f32 v34, 0, v34
    v_cvt_pk_bf16_f32 v35, 0, v35
    v_cvt_pk_bf16_f32 v36, 0, v36
    v_cvt_pk_bf16_f32 v37, 0, v37
    v_cvt_pk_bf16_f32 v38, 0, v38
    v_cvt_pk_bf16_f32 v39, 0, v39
    v_pk_mul_f32 v[32:33], v[32:33], v[20:21]
    v_pk_mul_f32 v[34:35], v[34:35], v[22:23]
    v_pk_mul_f32 v[36:37], v[36:37], v[28:29]
    v_pk_mul_f32 v[38:39], v[38:39], v[30:31]
    v_cvt_pk_bf16_f32 v212, v32, v33
    v_cvt_pk_bf16_f32 v213, v34, v35
    v_cvt_pk_bf16_f32 v214, v36, v37
    v_cvt_pk_bf16_f32 v215, v38, v39
    buffer_store_dwordx4 v[212:215], v8, s[52:55], s56 offen
    s_waitcnt vmcnt(0)
    s_mov_b64 exec, 1
    buffer_store_dword v210, v8, s[52:55], s56 offen offset:1024
    s_mov_b64 exec, -1
    s_barrier
L_phase2:
    s_barrier
    ds_read_b64_tr_b16 v[72:73], v206 offset:0
    ds_read_b64_tr_b16 v[74:75], v206 offset:2048
    ds_read_b64_tr_b16 v[76:77], v207 offset:0
    ds_read_b64_tr_b16 v[78:79], v207 offset:2048
    ds_read_b64_tr_b16 v[64:65], v204 offset:0
    ds_read_b64_tr_b16 v[66:67], v204 offset:2048
    ds_read_b64_tr_b16 v[68:69], v205 offset:0
    ds_read_b64_tr_b16 v[70:71], v205 offset:2048
    ds_read_b64_tr_b16 v[88:89], v206 offset:4096
    ds_read_b64_tr_b16 v[90:91], v206 offset:6144
    ds_read_b64_tr_b16 v[92:93], v207 offset:4096
    ds_read_b64_tr_b16 v[94:95], v207 offset:6144
    ds_read_b64_tr_b16 v[80:81], v204 offset:4096
    ds_read_b64_tr_b16 v[82:83], v204 offset:6144
    ds_read_b64_tr_b16 v[84:85], v205 offset:4096
    ds_read_b64_tr_b16 v[86:87], v205 offset:6144
    ds_read_b64_tr_b16 v[104:105], v206 offset:8192
    ds_read_b64_tr_b16 v[106:107], v206 offset:10240
    ds_read_b64_tr_b16 v[108:109], v207 offset:8192
    ds_read_b64_tr_b16 v[110:111], v207 offset:10240
    ds_read_b64_tr_b16 v[96:97], v204 offset:8192
    ds_read_b64_tr_b16 v[98:99], v204 offset:10240
    ds_read_b64_tr_b16 v[100:101], v205 offset:8192
    ds_read_b64_tr_b16 v[102:103], v205 offset:10240
    v_mov_b32 v209, s95
    s_mov_b64 exec, 0x7f
    buffer_load_dword v209, v208, s[52:55], s93 offen offset:1024 sc1
    s_mov_b64 exec, -1
    s_barrier
    s_branch L_chkH
L_slowH:
    s_cmp_ge_u32 s90, 1048576
    s_cbranch_scc1 L_done
    s_xor_b32 s57, s57, 1048576
    s_xor_b32 s59, s59, 1048576
    s_xor_b32 s93, s93, 1048576
    s_xor_b32 s95, s95, s92
    s_cmp_eq_u32 s94, 0
    s_cbranch_scc1 L_poll1
    buffer_store_dwordx4 v[212:215], v8, s[52:55], s58 offen sc1
    s_waitcnt vmcnt(0)
    s_mov_b64 exec, 0xff
    buffer_store_dwordx4 v[4:7], v8, s[52:55], s58 offen offset:1024 sc1
    s_mov_b64 exec, -1
    s_mov_b32 s94, 0
    s_branch L_poll1
L_pollH:
    s_add_u32 s90, s90, 1
    s_cmp_ge_u32 s90, 24
    s_cbranch_scc1 L_slowH
L_poll1:
    v_mov_b32 v209, s95
    s_mov_b64 exec, 0x7f
    buffer_load_dword v209, v208, s[52:55], s93 offen offset:1024 sc1
    s_mov_b64 exec, -1
L_chkH:
    s_waitcnt vmcnt(0)
    v_cmp_ne_u32 vcc, s95, v209
    s_cbranch_vccnz L_pollH
    buffer_load_dwordx4 v[176:179], v8, s[52:55], s59 offen offset:0 sc1
    ds_read_b64_tr_b16 v[120:121], v206 offset:12288
    ds_read_b64_tr_b16 v[122:123], v206 offset:14336
    ds_read_b64_tr_b16 v[124:125], v207 offset:12288
    ds_read_b64_tr_b16 v[126:127], v207 offset:14336
    ds_read_b64_tr_b16 v[112:113], v204 offset:12288
    ds_read_b64_tr_b16 v[114:115], v204 offset:14336
    buffer_load_dwordx4 v[180:183], v8, s[52:55], s59 offen offset:1152 sc1
    ds_read_b64_tr_b16 v[116:117], v205 offset:12288
    ds_read_b64_tr_b16 v[118:119], v205 offset:14336
    ds_read_b64_tr_b16 v[136:137], v206 offset:16384
    ds_read_b64_tr_b16 v[138:139], v206 offset:18432
    ds_read_b64_tr_b16 v[140:141], v207 offset:16384
    ds_read_b64_tr_b16 v[142:143], v207 offset:18432
    buffer_load_dwordx4 v[184:187], v8, s[52:55], s59 offen offset:2304 sc1
    ds_read_b64_tr_b16 v[128:129], v204 offset:16384
    ds_read_b64_tr_b16 v[130:131], v204 offset:18432
    ds_read_b64_tr_b16 v[132:133], v205 offset:16384
    ds_read_b64_tr_b16 v[134:135], v205 offset:18432
    ds_read_b64_tr_b16 v[152:153], v206 offset:20480
    ds_read_b64_tr_b16 v[154:155], v206 offset:22528
    buffer_load_dwordx4 v[188:191], v8, s[52:55], s57 offen offset:0 sc1
    ds_read_b64_tr_b16 v[156:157], v207 offset:20480
    ds_read_b64_tr_b16 v[158:159], v207 offset:22528
    ds_read_b64_tr_b16 v[144:145], v204 offset:20480
    ds_read_b64_tr_b16 v[146:147], v204 offset:22528
    ds_read_b64_tr_b16 v[148:149], v205 offset:20480
    ds_read_b64_tr_b16 v[150:151], v205 offset:22528
    buffer_load_dwordx4 v[192:195], v8, s[52:55], s57 offen offset:1152 sc1
    ds_read_b64_tr_b16 v[168:169], v206 offset:24576
    ds_read_b64_tr_b16 v[170:171], v206 offset:26624
    ds_read_b64_tr_b16 v[172:173], v207 offset:24576
    ds_read_b64_tr_b16 v[174:175], v207 offset:26624
    ds_read_b64_tr_b16 v[160:161], v204 offset:24576
    ds_read_b64_tr_b16 v[162:163], v204 offset:26624
    buffer_load_dwordx4 v[196:199], v8, s[52:55], s57 offen offset:2304 sc1
    ds_read_b64_tr_b16 v[164:165], v205 offset:24576
    ds_read_b64_tr_b16 v[166:167], v205 offset:26624
    buffer_load_dwordx4 v[200:203], v8, s[52:55], s57 offen offset:3456 sc1
    s_waitcnt vmcnt(6) lgkmcnt(14)
    v_mfma_f32_16x16x32_bf16 v[24:27], v[72:75], v[176:179], 0
    v_mfma_f32_16x16x32_bf16 v[28:31], v[76:79], v[176:179], 0
    v_mfma_f32_16x16x32_bf16 v[16:19], v[64:67], v[176:179], 0
    v_mfma_f32_16x16x32_bf16 v[20:23], v[68:71], v[176:179], 0
    s_waitcnt vmcnt(5) lgkmcnt(14)
    v_mfma_f32_16x16x32_bf16 v[24:27], v[88:91], v[180:183], v[24:27]
    v_mfma_f32_16x16x32_bf16 v[28:31], v[92:95], v[180:183], v[28:31]
    v_mfma_f32_16x16x32_bf16 v[16:19], v[80:83], v[180:183], v[16:19]
    v_mfma_f32_16x16x32_bf16 v[20:23], v[84:87], v[180:183], v[20:23]
    s_waitcnt vmcnt(4) lgkmcnt(14)
    v_mfma_f32_16x16x32_bf16 v[24:27], v[104:107], v[184:187], v[24:27]
    v_mfma_f32_16x16x32_bf16 v[28:31], v[108:111], v[184:187], v[28:31]
    v_mfma_f32_16x16x32_bf16 v[16:19], v[96:99], v[184:187], v[16:19]
    v_mfma_f32_16x16x32_bf16 v[20:23], v[100:103], v[184:187], v[20:23]
    s_waitcnt vmcnt(3) lgkmcnt(14)
    v_mfma_f32_16x16x32_bf16 v[24:27], v[120:123], v[188:191], v[24:27]
    v_mfma_f32_16x16x32_bf16 v[28:31], v[124:127], v[188:191], v[28:31]
    v_mfma_f32_16x16x32_bf16 v[16:19], v[112:115], v[188:191], v[16:19]
    v_mfma_f32_16x16x32_bf16 v[20:23], v[116:119], v[188:191], v[20:23]
    s_waitcnt vmcnt(2) lgkmcnt(14)
    v_mfma_f32_16x16x32_bf16 v[24:27], v[136:139], v[192:195], v[24:27]
    v_mfma_f32_16x16x32_bf16 v[28:31], v[140:143], v[192:195], v[28:31]
    v_mfma_f32_16x16x32_bf16 v[16:19], v[128:131], v[192:195], v[16:19]
    v_mfma_f32_16x16x32_bf16 v[20:23], v[132:135], v[192:195], v[20:23]
    s_waitcnt vmcnt(1) lgkmcnt(8)
    v_mfma_f32_16x16x32_bf16 v[24:27], v[152:155], v[196:199], v[24:27]
    v_mfma_f32_16x16x32_bf16 v[28:31], v[156:159], v[196:199], v[28:31]
    v_mfma_f32_16x16x32_bf16 v[16:19], v[144:147], v[196:199], v[16:19]
    v_mfma_f32_16x16x32_bf16 v[20:23], v[148:151], v[196:199], v[20:23]
    s_waitcnt vmcnt(0) lgkmcnt(0)
    v_mfma_f32_16x16x32_bf16 v[24:27], v[168:171], v[200:203], v[24:27]
    v_mfma_f32_16x16x32_bf16 v[28:31], v[172:175], v[200:203], v[28:31]
    v_mfma_f32_16x16x32_bf16 v[16:19], v[160:163], v[200:203], v[16:19]
    v_mfma_f32_16x16x32_bf16 v[20:23], v[164:167], v[200:203], v[20:23]
    s_nop 4
    ds_write_b128 v9, v[24:27]
    ds_write_b128 v9, v[28:31] offset:1024
    s_waitcnt lgkmcnt(0)
    s_barrier
    ds_read_b128 v[24:27], v10
    ds_read_b128 v[28:31], v10 offset:1024
    s_waitcnt lgkmcnt(1)
    v_pk_add_f32 v[16:17], v[16:17], v[24:25]
    v_pk_add_f32 v[18:19], v[18:19], v[26:27]
    v_bfi_b32 v16, v1, s48, v16
    v_bfi_b32 v17, v1, s49, v17
    v_bfi_b32 v18, v1, s50, v18
    v_bfi_b32 v19, v1, s51, v19
    buffer_store_dwordx4 v[16:19], v15, s[52:55], s62 offen offset:0 sc1
    s_waitcnt lgkmcnt(0)
    v_pk_add_f32 v[20:21], v[20:21], v[28:29]
    v_pk_add_f32 v[22:23], v[22:23], v[30:31]
    v_bfi_b32 v20, v1, s48, v20
    v_bfi_b32 v21, v1, s49, v21
    v_bfi_b32 v22, v1, s50, v22
    v_bfi_b32 v23, v1, s51, v23
    buffer_store_dwordx4 v[20:23], v15, s[52:55], s62 offen offset:256 sc1
    s_barrier
    s_cmp_eq_u32 s94, 0
    s_cbranch_scc1 L_pub
    v_mov_b32 v209, v210
    s_mov_b32 exec_hi, 0
    buffer_load_dword v209, v216, s[52:55], 0 offen sc1
    s_mov_b32 exec_hi, -1
    s_waitcnt vmcnt(0)
    v_cmp_ne_u32 vcc, v210, v209
    s_cbranch_vccz L_pub
    buffer_store_dwordx4 v[212:215], v8, s[52:55], s58 offen sc1
    s_waitcnt vmcnt(0)
    s_mov_b64 exec, 0xff
    buffer_store_dwordx4 v[4:7], v8, s[52:55], s58 offen offset:1024 sc1
    s_mov_b64 exec, -1
L_pub:
    s_or_b32 s57, s2, s3
    s_cmp_lg_u32 s57, 0
    s_cbranch_scc1 L_done
    s_mov_b32 s90, 0
    s_mov_b32 s57, 18432
    v_min_u32 v44, 47, v2
    v_mul_u32_u24 v44, 384, v44
L_pollE:
    s_add_u32 s90, s90, 1
    s_cmp_ge_u32 s90, 1048576
    s_cbranch_scc1 L_done
    buffer_load_dword v40, v44, s[52:55], s57 offen offset:0 sc1
    buffer_load_dword v41, v44, s[52:55], s57 offen offset:128 sc1
    buffer_load_dword v42, v44, s[52:55], s57 offen offset:256 sc1
    s_waitcnt vmcnt(0)
    v_xor_b32 v3, s26, v40
    v_bitop3_b32 v3, v41, s26, v3 bitop3:0xbe
    v_bitop3_b32 v3, v42, s26, v3 bitop3:0xbe
    v_cmp_ne_u32 vcc, 0, v3
    s_cbranch_vccnz L_pollE
    s_add_u32 s57, s25, 0x01010101
    v_mov_b32 v3, s57
    v_mov_b32 v4, 0
    s_barrier
    s_mov_b64 exec, 1
    buffer_store_dword v3, v4, s[52:55], 0 offen offset:0
    s_mov_b64 exec, -1
L_done:
    s_endpgm
.section .rodata,"a"
.p2align 6
.amdhsa_kernel standalone__geglu_ffn__sampling_kernel
  .amdhsa_next_free_vgpr 224
  .amdhsa_next_free_sgpr 98
  .amdhsa_accum_offset 224
  .amdhsa_group_segment_fixed_size 0
  .amdhsa_kernarg_size 56
  .amdhsa_user_sgpr_count 2
  .amdhsa_user_sgpr_kernarg_segment_ptr 1
  .amdhsa_system_sgpr_workgroup_id_x 1
.end_amdhsa_kernel
```
